```python
import torch

def _softmax(x, axis=-1):
    return torch.softmax(x, dim=axis)
def _gelu(x):
    return torch.nn.functional.gelu(x, approximate="tanh")
def _silu(x):
    return torch.nn.functional.silu(x)
def _sigmoid(x):
    return torch.sigmoid(x)
def _layernorm(x, axis=-1, eps=1e-5):
    m = x.mean(dim=axis, keepdim=True)
    v = x.var(dim=axis, keepdim=True, unbiased=False)
    return (x - m) / torch.sqrt(v + eps)
def _scatter_add(tgt, idx, src, axis=0):
    return tgt.clone().index_add_(axis, idx, src)
def _segment_sum(src, seg, n):
    out = torch.zeros((n,) + src.shape[1:], dtype=src.dtype)
    return out.index_add_(0, seg, src)
def _pad(x, pw):
    flat = tuple(v for pair in reversed(pw) for v in pair)
    return torch.nn.functional.pad(x, flat)

kernel_name = 'sequential_preLN__sliding_block_cached__glu_gated_geglu__decode'

def setup_inputs():

    _w = (lambda a: (lambda t: t.to(torch.bfloat16) if t.is_floating_point() else t)(torch.as_tensor(a)))
    def _A_setup():
        B, Sq, D = 1, 1, 576
        Hq, Hkv, Sk, Dh = 32, 16, 8192, 128
        assert Hq % Hkv == 0, (Hq, Hkv)
        return {
            "x": _w((lambda *s: torch.randn(*s, dtype=torch.bfloat16) * 0.05)(B, Sq, D)),
            "k_cache": _w((lambda *s: torch.randn(*s, dtype=torch.bfloat16) * 1.6)(B, Hkv, Sk, Dh)),
            "v_cache": _w((lambda *s: torch.randn(*s, dtype=torch.bfloat16) * 0.8)(B, Hkv, Sk, Dh)),
            "wq": _w((lambda *s: torch.randn(*s, dtype=torch.bfloat16) * 1.6)(D, Hq * Dh) * (D ** -0.5)),
            "wo": _w((lambda *s: torch.randn(*s, dtype=torch.bfloat16) * 0.8)(Hq * Dh, D) * ((Hq * Dh) ** -0.5)),
        }
    _A_in = _A_setup()

    def _B_setup():
        B, S, Dm, Df = 1, 1, 576, 4608
        return {
            "x": _w((lambda *s: torch.randn(*s, dtype=torch.bfloat16) * 0.05)(B, S, Dm)),
            "w_gate": _w((lambda *s: torch.randn(*s, dtype=torch.bfloat16) * 0.4)(Dm, Df) * (Dm ** -0.5)),
            "w_up": _w((lambda *s: torch.randn(*s, dtype=torch.bfloat16) * 0.4)(Dm, Df) * (Dm ** -0.5)),
            "w_down": _w((lambda *s: torch.randn(*s, dtype=torch.bfloat16) * 0.4)(Df, Dm) * (Df ** -0.5)),
        }
    _B_in = _B_setup()

    return {
        "A_x": _A_in["x"],
        "A_k_cache": _A_in["k_cache"],
        "A_v_cache": _A_in["v_cache"],
        "A_wq": _A_in["wq"],
        "A_wo": _A_in["wo"],
        "B_x": _B_in["x"],
        "B_w_gate": _B_in["w_gate"],
        "B_w_up": _B_in["w_up"],
        "B_w_down": _B_in["w_down"],
    }

def reference(A_x, A_k_cache, A_v_cache, A_wq, A_wo, B_x, B_w_gate, B_w_up, B_w_down):
    def _A_ref(x, k_cache, v_cache, wq, wo):
        B, Sq, D = x.shape
        Hq, Dh = 32, 128
        Hkv, Sk = k_cache.shape[1], k_cache.shape[2]
        W = min(4096, max(256, Sk // 4))
        rep = Hq // Hkv
        q = (lambda x, *d: x.permute(*d))((x @ wq).reshape(B, Sq, Hq, Dh), 0, 2, 1, 3)
        k = (lambda x, n, axis: torch.repeat_interleave(x, n, dim=axis))(k_cache[:, :, Sk - W:, :], rep, axis=1)
        v = (lambda x, n, axis: torch.repeat_interleave(x, n, dim=axis))(v_cache[:, :, Sk - W:, :], rep, axis=1)
        scores = torch.einsum("bhqd,bhkd->bhqk", q, k) * (Dh ** -0.5)
        p = _softmax(scores, axis=-1)
        o = torch.einsum("bhqk,bhkd->bhqd", p, v)
        return (lambda x, *d: x.permute(*d))(o, 0, 2, 1, 3).reshape(B, Sq, Hq * Dh) @ wo

    def _B_ref(x, w_gate, w_up, w_down):
        g = torch.einsum("bsd,df->bsf", x, w_gate)
        u = torch.einsum("bsd,df->bsf", x, w_up)
        h = _gelu(g) * u
        return torch.einsum("bsf,fd->bsd", h, w_down)

    x = A_x
    h = x + _A_ref(_layernorm(x, axis=-1), A_k_cache, A_v_cache, A_wq, A_wo)
    h2 = h + _B_ref(_layernorm(h, axis=-1), B_w_gate, B_w_up, B_w_down)
    return h2
```

```asm
; @launch grid=(256,1,1) block=(384,1,1) lds=131072
.amdgcn_target "amdgcn-amd-amdhsa--gfx950"
.text
.globl sequential_preLN__sliding_block_cached__glu_gated_geglu__decode_kernel
.p2align 8
.type sequential_preLN__sliding_block_cached__glu_gated_geglu__decode_kernel,@function
sequential_preLN__sliding_block_cached__glu_gated_geglu__decode_kernel:
    s_cmpk_ge_u32 s2, 256
    s_cbranch_scc1 L_end
    s_load_dwordx16 s[8:23], s[0:1], 0
    s_load_dwordx8 s[24:31], s[0:1], 64
    s_cmpk_lt_u32 s2, 248
    s_cbranch_scc1 L_nopf
    s_getpc_b64 s[60:61]
    v_lshlrev_b32 v12, 5, v0
    global_load_dword v7, v12, s[60:61] offset:192
L_nopf:
    v_readfirstlane_b32 s37, v0
    v_and_b32 v3, 15, v0
    v_lshrrev_b32 v2, 4, v0
    s_and_b32 s32, s2, 7
    s_lshr_b32 s33, s2, 3
    s_cmpk_eq_u32 s37, 320
    s_cbranch_scc1 L_toucher
    s_and_b32 s44, s33, 7
    s_mulk_i32 s44, 2304
    s_lshr_b32 s45, s33, 3
    s_lshl2_add_u32 s45, s32, s45
    s_add_u32 s46, s44, s45
    s_lshl_b32 s46, s46, 8
    v_lshl_add_u32 v8, v3, 4, s46
    v_lshl_add_u32 v8, v2, 13, v8
    v_add_u32 v9, 163840, v8
    v_add_u32 v10, 294912, v8
    v_add_u32 v11, 425984, v8
    v_lshlrev_b32 v6, 4, v0
    v_lshlrev_b32 v13, 1, v0
    s_cmp_eq_u32 s37, 0
    s_waitcnt lgkmcnt(0)
    s_cbranch_scc0 L_nx
    global_load_dwordx4 v[50:53], v6, s[8:9]
    global_load_ushort v22, v13, s[8:9] offset:1024
L_nx:
    global_load_dwordx4 v[54:57], v8, s[14:15] nt
    global_load_dwordx4 v[58:61], v9, s[14:15] nt
    s_load_dword s39, s[30:31], 0
    s_cbranch_scc1 L_nq
    global_load_dwordx4 v[62:65], v10, s[14:15] nt
    global_load_dwordx4 v[66:69], v11, s[14:15] nt
L_nq:
    v_and_b32 v1, 63, v0
    v_and_b32 v2, 3, v2
    v_lshlrev_b32 v6, 4, v1
    s_lshl_b32 s34, s32, 5
    s_add_u32 s34, s34, s33
    s_lshr_b32 s35, s34, 4
    s_and_b32 s36, s33, 15
    s_lshr_b32 s37, s37, 6
    s_sub_u32 s37, s37, 1
    s_cbranch_scc1 L_helper
    s_lshl_b32 s46, s35, 21
    s_lshl_b32 s47, s36, 15
    s_add_u32 s46, s46, s47
    s_lshl_b32 s47, s37, 13
    s_add_u32 s46, s46, s47
    s_add_u32 s46, s46, 0x180000
    s_add_u32 m0, s47, 20480
    s_add_u32 s47, s36, s37
    s_and_b32 s47, s47, 7
    s_lshl_b32 s47, s47, 10
    s_add_u32 s46, s46, s47
    v_xor_b32 v8, v3, v2
    v_lshl_add_u32 v22, v8, 4, s46
    v_lshl_add_u32 v22, v2, 8, v22
    v_add_u32 v23, s46, v6
    global_load_lds_dwordx4 v22, s[10:11] nt
    s_addk_i32 m0, 0x400
    v_xor_b32 v19, 1088, v22
    global_load_lds_dwordx4 v19, s[10:11] nt
    s_mov_b32 s54, 0xffff0000
    s_mov_b32 s53, 0
    s_mov_b32 s48, 0x7060500
    s_mov_b32 s49, 0x7060501
    s_mov_b32 s50, 0x7060502
    s_mov_b32 s51, 0x7060503
    s_mov_b32 s52, 0x0c0c0400
    v_and_b32 v12, 3, v0
    v_and_b32 v13, 1, v0
    v_lshlrev_b32 v13, 17, v13
    v_or_b32 v12, v12, v13
    v_or_b32 v12, 0x10000, v12
    v_mul_u32_u24 v5, 0x5555, v12
    s_lshr_b32 s41, s33, 4
    s_mul_i32 s41, s41, 7
    s_add_u32 s41, s41, s36
    s_sub_u32 s41, s41, 9
    s_mul_i32 s42, s35, 9
    s_add_u32 s42, s42, s36
    s_cmp_lt_u32 s41, 9
    s_cselect_b32 s40, 1, 2
    s_cmp_lt_u32 s36, 9
    s_cselect_b32 s40, 0, s40
    s_and_b32 s43, s42, 1
    v_bfe_u32 v8, v0, 2, 1
    v_mul_u32_u24 v8, 640, v8
    v_lshl_add_u32 v8, v2, 4, v8
    s_lshl_b32 s44, s37, 7
    v_add_u32 v8, s44, v8
    v_lshl_add_u32 v9, v3, 1, v2
    s_lshl_b32 s44, s37, 9
    v_lshl_add_u32 v9, v9, 4, s44
    v_mov_b32 v30, 0
    v_mov_b32 v31, 0
    v_mov_b32 v32, 0
    v_mov_b32 v33, 0
    s_waitcnt vmcnt(5)
    s_addk_i32 m0, 0x400
    v_xor_b32 v19, 2176, v22
    global_load_lds_dwordx4 v19, s[10:11] nt
    s_barrier
    ds_read_b128 v[102:105], v8 offset:16384
    ds_read_b128 v[106:109], v8 offset:16448
    s_waitcnt vmcnt(5)
    s_addk_i32 m0, 0x400
    v_xor_b32 v19, 3264, v22
    global_load_lds_dwordx4 v19, s[10:11] nt
    s_waitcnt vmcnt(5)
    global_load_dwordx4 v[210:213], v23, s[12:13] nt
    s_waitcnt vmcnt(5)
    s_waitcnt lgkmcnt(0)
    v_smfmac_f32_16x16x64_bf16 v[30:33], v[102:105], v[54:61], v5
    v_smfmac_f32_16x16x64_bf16 v[30:33], v[106:109], v[62:69], v5
    s_add_u32 s38, s39, 0x01010101
    v_mov_b32 v4, s38
    s_bfm_b64 exec, 32, 0
    s_nop 4
    ds_write_b128 v9, v[30:33] offset:0
    s_mov_b64 exec, -1
    s_waitcnt lgkmcnt(0)
    s_barrier
    s_waitcnt vmcnt(4)
    s_addk_i32 m0, 0x400
    v_xor_b32 v19, 4096, v22
    global_load_lds_dwordx4 v19, s[10:11] nt
    v_bfe_u32 v8, v0, 3, 2
    v_bfe_u32 v9, v0, 5, 1
    v_lshl_add_u32 v8, v8, 1, v9
    v_and_b32 v9, 7, v0
    v_lshlrev_b32 v9, 4, v9
    s_movk_i32 s45, 1152
    v_mad_u32_u24 v10, v8, s45, v9
    s_mul_i32 s44, s42, 36864
    s_mul_i32 s45, s37, 384
    s_add_u32 s44, s44, s45
    v_add_u32 v24, s44, v10
    s_mul_i32 s55, s37, 18432
    s_add_u32 s55, s55, 57344
    s_mul_i32 s56, s37, 12288
    s_add_u32 s56, s56, 20480
    v_lshl_add_u32 v25, v1, 3, s55
    v_lshl_add_u32 v26, v1, 3, s56
    s_waitcnt vmcnt(4)
    v_xor_b32 v19, 1024, v23
    global_load_dwordx4 v[214:217], v19, s[12:13] nt
    s_mov_b32 s63, 0
    s_cmp_eq_u32 s40, 0
    s_cbranch_scc1 L_adF
    s_lshl_b32 s44, s32, 2
    s_add_u32 s44, s44, s37
    s_mul_i32 s44, s44, 147456
    s_lshl_b32 s45, s41, 7
    s_add_u32 s44, s44, s45
    v_add_u32 v10, s44, v10
    v_mov_b32 v20, s16
    v_mov_b32 v21, s17
    s_movk_i32 s62, 9216
    s_sub_u32 s44, s41, 9
    s_lshl2_add_u32 s44, s44, s37
    s_and_b32 s44, s44, 15
    s_bitcmp1_b32 s44, 0
    s_cselect_b32 s58, s22, s20
    s_cselect_b32 s59, s23, s21
    s_lshr_b32 s44, s44, 1
    s_mul_i32 s44, s44, 663552
    s_sub_u32 s45, 3, s32
    s_and_b32 s45, s45, 7
    s_mul_i32 s46, s32, 9
    s_add_u32 s45, s45, s46
    s_lshl_b32 s45, s45, 7
    s_add_u32 s44, s44, s45
    s_add_u32 s44, s44, 221184
    v_min_u32 v27, 31, v1
    v_mul_u32_u24 v27, 9216, v27
    v_add_u32 v27, s44, v27
    s_branch L_adX
L_adF:
    s_lshl1_add_u32 s44, s37, s43
    s_mul_i32 s44, s44, 663552
    s_lshl_b32 s45, s42, 6
    s_add_u32 s44, s44, s45
    v_and_b32 v10, 48, v9
    v_add_u32 v10, s44, v10
    s_movk_i32 s45, 9216
    v_mad_u32_u24 v10, v8, s45, v10
    v_cmp_gt_u32 vcc, 64, v9
    v_mov_b32 v11, s22
    v_mov_b32 v12, s23
    v_mov_b32 v13, s20
    v_mov_b32 v14, s21
    v_cndmask_b32 v20, v11, v13, vcc
    v_cndmask_b32 v21, v12, v14, vcc
    s_lshl2_add_u32 s44, s32, s37
    s_mul_i32 s44, s44, 147456
    s_mul_i32 s45, s32, 18
    s_sub_u32 s45, s42, s45
    s_lshl_b32 s45, s45, 11
    s_add_u32 s44, s44, s45
    s_add_u32 s44, s44, 36864
    v_lshl_add_u32 v27, v3, 7, s44
    s_mov_b64 s[58:59], s[20:21]
    s_mov_b32 s62, 73728
    s_mul_i32 s44, s43, 1327104
    s_sub_u32 s64, 73728, s44
    s_subb_u32 s65, 0, 0
L_adX:
    v_add_co_u32 v20, vcc, v20, v10
    s_nop 1
    v_addc_co_u32 v21, vcc, 0, v21, vcc
    s_waitcnt vmcnt(4)
    s_addk_i32 m0, 0x400
    v_xor_b32 v19, 5184, v22
    global_load_lds_dwordx4 v19, s[10:11] nt
    v_xor_b32 v8, v3, v2
    s_lshl_b32 s44, s37, 13
    s_add_u32 s44, s44, 20480
    v_lshl_add_u32 v8, v8, 4, s44
    v_lshl_add_u32 v8, v3, 8, v8
    v_xor_b32 v9, 64, v8
    v_xor_b32 v10, 128, v8
    v_xor_b32 v11, 192, v8
    v_bfe_u32 v16, v0, 2, 1
    v_lshlrev_b32 v12, 4, v2
    v_lshl_add_u32 v12, v16, 8, v12
    s_lshl_b32 s44, s37, 10
    v_bfe_u32 v13, v0, 2, 2
    v_lshl_add_u32 v13, v13, 8, s44
    v_lshl_add_u32 v13, v2, 4, v13
    v_and_b32 v15, 1, v2
    v_lshl_add_u32 v14, v15, 9, s44
    v_lshl_add_u32 v14, v3, 3, v14
    v_lshrrev_b32 v16, 1, v2
    v_lshl_add_u32 v14, v16, 7, v14
    v_add_u32 v14, 12288, v14
    v_lshl_add_u32 v50, v3, 1, v15
    v_lshl_add_u32 v50, v16, 5, v50
    v_lshl_add_u32 v50, v50, 4, s44
    s_lshl_b32 s44, s37, 2
    v_lshl_add_u32 v15, v15, 4, s44
    s_bfm_b64 s[60:61], 32, 32
    s_waitcnt vmcnt(4)
    v_xor_b32 v19, 2048, v23
    global_load_dwordx4 v[218:221], v19, s[12:13] nt
    ds_read_b128 v[138:141], v8 offset:0
    ds_read_b128 v[142:145], v9 offset:0
    ds_read_b128 v[146:149], v10 offset:0
    ds_read_b128 v[150:153], v11 offset:0
    s_waitcnt vmcnt(4)
    s_addk_i32 m0, 0x400
    v_xor_b32 v19, 6272, v22
    global_load_lds_dwordx4 v19, s[10:11] nt
    s_waitcnt vmcnt(4)
    v_xor_b32 v19, 3072, v23
    global_load_dwordx4 v[222:225], v19, s[12:13] nt
    s_waitcnt vmcnt(4)
    s_addk_i32 m0, 0x400
    v_xor_b32 v19, 7360, v22
    global_load_lds_dwordx4 v19, s[10:11] nt
    s_waitcnt vmcnt(4)
    v_xor_b32 v19, 4096, v23
    global_load_dwordx4 v[226:229], v19, s[12:13] nt
    v_xor_b32 v19, 5120, v23
    global_load_dwordx4 v[230:233], v19, s[12:13] nt
    v_xor_b32 v19, 6144, v23
    global_load_dwordx4 v[234:237], v19, s[12:13] nt
    s_waitcnt vmcnt(6)
    v_xor_b32 v19, 7168, v23
    global_load_dwordx4 v[238:241], v19, s[12:13] nt
    s_waitcnt vmcnt(6)
    s_waitcnt vmcnt(5)
    s_waitcnt vmcnt(4)
    ds_read_b128 v[154:157], v8 offset:4096
    ds_read_b128 v[158:161], v9 offset:4096
    ds_read_b128 v[162:165], v10 offset:4096
    ds_read_b128 v[166:169], v11 offset:4096
    s_waitcnt lgkmcnt(0)
    s_barrier
    ds_read_b128 v[102:105], v12 offset:2560
    ds_read_b128 v[106:109], v12 offset:2624
    ds_read_b128 v[110:113], v12 offset:2688
    ds_read_b128 v[114:117], v12 offset:2752
    s_cmp_eq_u32 s40, 1
    s_cbranch_scc1 L_E1w
    s_cmp_eq_u32 s40, 0
    s_cbranch_scc0 L_E1x
    s_bfm_b64 exec, 16, 0
    global_load_dword v7, v27, s[16:17]
    s_mov_b64 exec, -1
    v_add_u32 v27, 36864, v27
    s_branch L_E1x
L_E1w:
    s_add_u32 m0, s55, 0
    s_nop 0
    global_load_lds_dwordx4 v[20:21], off
    v_lshl_add_u64 v[20:21], s[62:63], 0, v[20:21]
    s_add_u32 m0, s55, 1024
    s_nop 0
    global_load_lds_dwordx4 v[20:21], off
    v_lshl_add_u64 v[20:21], s[62:63], 0, v[20:21]
    s_add_u32 m0, s55, 2048
    s_nop 0
    global_load_lds_dwordx4 v[20:21], off
    v_lshl_add_u64 v[20:21], s[62:63], 0, v[20:21]
    s_add_u32 m0, s55, 3072
    s_nop 0
    global_load_lds_dwordx4 v[20:21], off
    v_lshl_add_u64 v[20:21], s[62:63], 0, v[20:21]
L_E1x:
    s_waitcnt lgkmcnt(3)
    v_mfma_f32_16x16x32_bf16 v[30:33], v[102:105], v[138:141], 0
    v_mfma_f32_16x16x32_bf16 v[34:37], v[102:105], v[154:157], 0
    s_waitcnt lgkmcnt(2)
    v_mfma_f32_16x16x32_bf16 v[30:33], v[106:109], v[142:145], v[30:33]
    v_mfma_f32_16x16x32_bf16 v[34:37], v[106:109], v[158:161], v[34:37]
    s_waitcnt lgkmcnt(1)
    v_mfma_f32_16x16x32_bf16 v[30:33], v[110:113], v[146:149], v[30:33]
    v_mfma_f32_16x16x32_bf16 v[34:37], v[110:113], v[162:165], v[34:37]
    s_waitcnt lgkmcnt(0)
    v_mfma_f32_16x16x32_bf16 v[30:33], v[114:117], v[150:153], v[30:33]
    v_mfma_f32_16x16x32_bf16 v[34:37], v[114:117], v[166:169], v[34:37]
    s_cmp_eq_u32 s40, 1
    s_cbranch_scc1 L_E2w
    s_cmp_eq_u32 s40, 0
    s_cbranch_scc0 L_E2s
    s_bfm_b64 exec, 16, 0
    global_load_dword v7, v27, s[16:17]
    s_mov_b64 exec, -1
    v_add_u32 v27, 36864, v27
    s_branch L_E2x
L_E2s:
    s_bfm_b64 exec, 16, 0
    global_load_dword v7, v27, s[58:59]
    s_mov_b64 exec, -1
    s_branch L_E2x
L_E2w:
L_E2x:
    s_mov_b32 s45, 0x3db504f3
    s_mov_b32 s46, 0x3fb8aa3b
    s_nop 4
    v_cndmask_b32 v46, v30, v34, s[60:61]
    v_cvt_pk_bf16_f32 v46, 0, v46
    v_mul_f32 v46, s45, v46
    v_cvt_pk_bf16_f32 v46, 0, v46
    v_mov_b32 v47, v46
    v_mov_b32 v48, v46
    v_mov_b32 v30, 0
    v_mov_b32 v31, 0
    v_mov_b32 v32, 0
    v_mov_b32 v33, 0
    v_permlane32_swap_b32 v47, v48
    v_max_f32 v47, v47, v48
    s_nop 1
    v_max_f32_dpp v47, v47, v47 row_ror:8 row_mask:0xf bank_mask:0xf
    s_nop 1
    v_max_f32_dpp v47, v47, v47 row_ror:4 row_mask:0xf bank_mask:0xf
    s_nop 1
    v_max_f32_dpp v47, v47, v47 row_ror:2 row_mask:0xf bank_mask:0xf
    s_nop 1
    v_max_f32_dpp v47, v47, v47 row_ror:1 row_mask:0xf bank_mask:0xf
    v_sub_f32 v46, v46, v47
    v_mul_f32 v46, s46, v46
    v_exp_f32 v46, v46
    ds_write_b32 v15, v47 offset:3072
    v_cvt_pk_bf16_f32 v48, v46, 0
    ds_write2_b32 v14, v48, v48 offset0:0 offset1:65
    ds_read_b128 v[102:105], v13 offset:12288
    ds_read_b128 v[106:109], v13 offset:12352
    ds_read_b128 v[110:113], v13 offset:12416
    ds_read_b128 v[114:117], v13 offset:12480
    v_mov_b32 v47, v46
    s_nop 1
    v_permlane32_swap_b32 v46, v47
    v_add_f32 v46, v46, v47
    s_nop 1
    v_add_f32_dpp v46, v46, v46 row_ror:8 row_mask:0xf bank_mask:0xf
    s_nop 1
    v_add_f32_dpp v46, v46, v46 row_ror:4 row_mask:0xf bank_mask:0xf
    s_nop 1
    v_add_f32_dpp v46, v46, v46 row_ror:2 row_mask:0xf bank_mask:0xf
    s_nop 1
    v_add_f32_dpp v46, v46, v46 row_ror:1 row_mask:0xf bank_mask:0xf
    ds_write_b32 v15, v46 offset:3104
    s_cmp_eq_u32 s40, 1
    s_cbranch_scc1 L_E3w
    s_cmp_eq_u32 s40, 0
    s_cbranch_scc0 L_E3x
    s_bfm_b64 exec, 16, 0
    global_load_dword v7, v27, s[16:17]
    s_mov_b64 exec, -1
    s_branch L_E3x
L_E3w:
L_E3x:
    s_waitcnt lgkmcnt(0)
    s_barrier
    s_waitcnt vmcnt(6)
    s_cmp_eq_u32 s40, 1
    s_cbranch_scc1 L_M4
    s_waitcnt vmcnt(5)
    s_cmp_eq_u32 s40, 0
    s_cbranch_scc1 L_M4
    s_waitcnt vmcnt(3)
L_M4:
    v_smfmac_f32_16x16x64_bf16 v[30:33], v[102:105], v[210:217], v5
    v_smfmac_f32_16x16x64_bf16 v[30:33], v[106:109], v[218:225], v5
    v_smfmac_f32_16x16x64_bf16 v[30:33], v[110:113], v[226:233], v5
    s_waitcnt vmcnt(4)
    s_cmp_eq_u32 s40, 1
    s_cbranch_scc1 L_M5
    s_waitcnt vmcnt(3)
    s_cmp_eq_u32 s40, 0
    s_cbranch_scc1 L_M5
    s_waitcnt vmcnt(1)
L_M5:
    v_smfmac_f32_16x16x64_bf16 v[30:33], v[114:117], v[234:241], v5
    s_cmp_eq_u32 s40, 0
    s_nop 6
    ds_write_b128 v50, v[30:33] offset:4096
    s_waitcnt lgkmcnt(0)
    s_barrier
    s_barrier
    s_cbranch_scc1 L_roleF
    s_cmp_eq_u32 s40, 2
    s_cbranch_scc1 L_roleS
    s_lshr_b32 s44, s37, 1
    s_lshl1_add_u32 s44, s32, s44
    s_mul_i32 s44, s44, 18432
    s_add_u32 s44, s44, 196608
    s_and_b32 s45, s37, 1
    s_lshl_b32 s46, s45, 9
    s_add_u32 s46, s46, s44
    s_lshl4_add_u32 s45, s45, s44
    s_movk_i32 s47, 1152
    s_add_u32 m0, s55, 4096
    s_nop 0
    global_load_lds_dwordx4 v[20:21], off
    v_lshl_add_u64 v[20:21], s[62:63], 0, v[20:21]
    s_add_u32 m0, s55, 5120
    s_nop 0
    global_load_lds_dwordx4 v[20:21], off
    v_lshl_add_u64 v[20:21], s[62:63], 0, v[20:21]
    s_add_u32 m0, s55, 6144
    s_nop 0
    global_load_lds_dwordx4 v[20:21], off
    v_lshl_add_u64 v[20:21], s[62:63], 0, v[20:21]
    s_add_u32 m0, s55, 7168
    s_nop 0
    global_load_lds_dwordx4 v[20:21], off
    v_lshl_add_u64 v[20:21], s[62:63], 0, v[20:21]
    s_add_u32 m0, s55, 8192
    s_nop 0
    global_load_lds_dwordx4 v[20:21], off
    v_lshl_add_u64 v[20:21], s[62:63], 0, v[20:21]
    s_add_u32 m0, s55, 9216
    s_nop 0
    global_load_lds_dwordx4 v[20:21], off
    v_lshl_add_u64 v[20:21], s[62:63], 0, v[20:21]
    s_add_u32 m0, s55, 10240
    s_nop 0
    global_load_lds_dwordx4 v[20:21], off
    v_lshl_add_u64 v[20:21], s[62:63], 0, v[20:21]
    s_add_u32 m0, s55, 11264
    s_nop 0
    global_load_lds_dwordx4 v[20:21], off
    v_lshl_add_u64 v[20:21], s[62:63], 0, v[20:21]
    v_lshl_add_u32 v8, v3, 4, s46
    v_mad_u32_u24 v8, v2, s47, v8
    v_add_u32 v9, 4608, v8
    v_add_u32 v10, 9216, v8
    v_add_u32 v11, 13824, v8
    v_lshlrev_b32 v12, 1, v2
    v_xor_b32 v12, v3, v12
    v_mov_b32 v13, s45
    v_mad_u32_u24 v12, v12, s47, v13
    s_mul_i32 s44, s37, 640
    v_add_u32 v13, s44, v6
    v_lshl_add_u32 v14, v2, 4, s44
    s_lshl_b32 s44, s37, 9
    v_add_u32 v15, s44, v6
    s_mov_b32 s45, 0x3fb8aa3b
    s_mov_b32 s46, 0x05040100
    v_bfe_u32 v16, v0, 1, 3
    v_cmp_eq_u32 vcc, 0, v16
    s_nop 1
    v_cndmask_b32 v50, 0, -1, vcc
    v_cmp_eq_u32 vcc, 1, v16
    s_nop 1
    v_cndmask_b32 v51, 0, -1, vcc
    v_cmp_eq_u32 vcc, 2, v16
    s_nop 1
    v_cndmask_b32 v52, 0, -1, vcc
    v_cmp_eq_u32 vcc, 3, v16
    s_nop 1
    v_cndmask_b32 v53, 0, -1, vcc
    s_waitcnt vmcnt(11)
    ds_read_b64 v[170:171], v25 offset:0
    ds_read_b64 v[172:173], v25 offset:512
    s_add_u32 m0, s55, 12288
    s_nop 0
    global_load_lds_dwordx4 v[20:21], off
    v_lshl_add_u64 v[20:21], s[62:63], 0, v[20:21]
    s_waitcnt vmcnt(11)
    ds_read_b64 v[174:175], v25 offset:1024
    ds_read_b64 v[176:177], v25 offset:1536
    s_add_u32 m0, s55, 13312
    s_nop 0
    global_load_lds_dwordx4 v[20:21], off
    v_lshl_add_u64 v[20:21], s[62:63], 0, v[20:21]
    s_waitcnt vmcnt(11)
    ds_read_b64 v[178:179], v25 offset:2048
    ds_read_b64 v[180:181], v25 offset:2560
    s_add_u32 m0, s55, 14336
    s_nop 0
    global_load_lds_dwordx4 v[20:21], off
    v_lshl_add_u64 v[20:21], s[62:63], 0, v[20:21]
    s_waitcnt vmcnt(11)
    ds_read_b64 v[182:183], v25 offset:3072
    ds_read_b64 v[184:185], v25 offset:3584
    s_add_u32 m0, s55, 15360
    s_nop 0
    global_load_lds_dwordx4 v[20:21], off
    s_lshl2_add_u32 s44, s41, s37
    s_lshl_b32 s44, s44, 9
    s_lshl2_add_u32 s44, s32, s44
    s_add_u32 s44, s44, 983040
    v_and_b32 v22, 3, v0
    v_lshl_add_u32 v22, v22, 7, s44
    v_mov_b32 v34, 0
    v_mov_b32 v35, 0
    v_mov_b32 v36, 0
    v_mov_b32 v37, 0
    s_add_u32 s66, s30, 1310720
    s_addc_u32 s67, s31, 0
    s_mov_b32 s68, 0
L_ospin:
    global_load_dwordx4 v[46:49], v12, s[66:67] offset:1024 sc1
    global_load_dwordx4 v[138:141], v8, s[66:67] offset:0 sc1
    global_load_dwordx4 v[142:145], v9, s[66:67] offset:0 sc1
    global_load_dwordx4 v[146:149], v8, s[66:67] offset:256 sc1
    global_load_dwordx4 v[150:153], v9, s[66:67] offset:256 sc1
    global_load_dwordx4 v[154:157], v10, s[66:67] offset:0 sc1
    global_load_dwordx4 v[158:161], v11, s[66:67] offset:0 sc1
    global_load_dwordx4 v[162:165], v10, s[66:67] offset:256 sc1
    global_load_dwordx4 v[166:169], v11, s[66:67] offset:256 sc1
    s_waitcnt vmcnt(20)
    ds_read_b64 v[186:187], v25 offset:4096
    ds_read_b64 v[188:189], v25 offset:4608
    s_waitcnt vmcnt(19)
    ds_read_b64 v[190:191], v25 offset:5120
    ds_read_b64 v[192:193], v25 offset:5632
    s_waitcnt vmcnt(18)
    ds_read_b64 v[194:195], v25 offset:6144
    ds_read_b64 v[196:197], v25 offset:6656
    s_waitcnt vmcnt(17)
    ds_read_b64 v[198:199], v25 offset:7168
    ds_read_b64 v[200:201], v25 offset:7680
    s_waitcnt vmcnt(16)
    ds_read_b64 v[202:203], v25 offset:8192
    ds_read_b64 v[204:205], v25 offset:8704
    s_waitcnt vmcnt(15)
    ds_read_b64 v[206:207], v25 offset:9216
    ds_read_b64 v[208:209], v25 offset:9728
    s_waitcnt vmcnt(14)
    ds_read_b64 v[210:211], v25 offset:10240
    ds_read_b64 v[212:213], v25 offset:10752
    s_waitcnt vmcnt(13)
    ds_read_b64 v[214:215], v25 offset:11264
    ds_read_b64 v[216:217], v25 offset:11776
    s_waitcnt vmcnt(12)
    ds_read_b64 v[218:219], v25 offset:12288
    ds_read_b64 v[220:221], v25 offset:12800
    s_waitcnt vmcnt(11)
    ds_read_b64 v[222:223], v25 offset:13312
    ds_read_b64 v[224:225], v25 offset:13824
    s_waitcnt vmcnt(10)
    ds_read_b64 v[226:227], v25 offset:14336
    ds_read_b64 v[228:229], v25 offset:14848
    s_waitcnt vmcnt(9)
    ds_read_b64 v[230:231], v25 offset:15360
    ds_read_b64 v[232:233], v25 offset:15872
    v_mov_b32 v30, 0
    v_mov_b32 v31, 0
    v_mov_b32 v32, 0
    v_mov_b32 v33, 0
    s_waitcnt vmcnt(8)
    v_max_f32_dpp v16, v46, v46 row_ror:8 row_mask:0xf bank_mask:0xf
    s_nop 1
    v_max_f32_dpp v16, v16, v16 row_ror:4 row_mask:0xf bank_mask:0xf
    s_nop 1
    v_max_f32_dpp v16, v16, v16 row_ror:2 row_mask:0xf bank_mask:0xf
    s_nop 1
    v_max_f32_dpp v16, v16, v16 row_ror:1 row_mask:0xf bank_mask:0xf
    v_sub_f32 v16, v46, v16
    v_mul_f32 v16, s45, v16
    v_exp_f32 v16, v16
    v_xor_b32 v17, v49, v4
    v_mul_f32 v16, v16, v47
    s_nop 1
    v_add_f32_dpp v18, v16, v16 row_ror:8 row_mask:0xf bank_mask:0xf
    s_nop 1
    v_add_f32_dpp v18, v18, v18 row_ror:4 row_mask:0xf bank_mask:0xf
    s_nop 1
    v_add_f32_dpp v18, v18, v18 row_ror:2 row_mask:0xf bank_mask:0xf
    s_nop 1
    v_add_f32_dpp v18, v18, v18 row_ror:1 row_mask:0xf bank_mask:0xf
    v_rcp_f32 v18, v18
    s_nop 0
    v_mul_f32 v16, v16, v18
    v_cvt_pk_bf16_f32 v18, 0, v16
    v_sub_f32 v18, v16, v18
    v_cvt_pk_bf16_f32 v16, v16, v18
    s_nop 1
    v_and_b32_dpp v102, v16, v50 row_newbcast:0 row_mask:0xf bank_mask:0xf
    v_and_b32_dpp v103, v16, v51 row_newbcast:0 row_mask:0xf bank_mask:0xf
    v_and_b32_dpp v104, v16, v50 row_newbcast:1 row_mask:0xf bank_mask:0xf
    v_and_b32_dpp v105, v16, v51 row_newbcast:1 row_mask:0xf bank_mask:0xf
    v_and_b32_dpp v106, v16, v52 row_newbcast:0 row_mask:0xf bank_mask:0xf
    v_and_b32_dpp v107, v16, v53 row_newbcast:0 row_mask:0xf bank_mask:0xf
    v_and_b32_dpp v108, v16, v52 row_newbcast:1 row_mask:0xf bank_mask:0xf
    v_and_b32_dpp v109, v16, v53 row_newbcast:1 row_mask:0xf bank_mask:0xf
    v_and_b32_dpp v110, v16, v50 row_newbcast:8 row_mask:0xf bank_mask:0xf
    v_and_b32_dpp v111, v16, v51 row_newbcast:8 row_mask:0xf bank_mask:0xf
    v_and_b32_dpp v112, v16, v50 row_newbcast:9 row_mask:0xf bank_mask:0xf
    v_and_b32_dpp v113, v16, v51 row_newbcast:9 row_mask:0xf bank_mask:0xf
    v_and_b32_dpp v114, v16, v52 row_newbcast:8 row_mask:0xf bank_mask:0xf
    v_and_b32_dpp v115, v16, v53 row_newbcast:8 row_mask:0xf bank_mask:0xf
    v_and_b32_dpp v116, v16, v52 row_newbcast:9 row_mask:0xf bank_mask:0xf
    v_and_b32_dpp v117, v16, v53 row_newbcast:9 row_mask:0xf bank_mask:0xf
    s_waitcnt vmcnt(6)
    v_smfmac_f32_16x16x64_bf16 v[30:33], v[102:105], v[138:145], v5 abid:1
    v_perm_b32 v18, v139, v138, s46
    v_bitop3_b32 v17, v18, v4, v17 bitop3:0xbe
    v_perm_b32 v18, v143, v142, s46
    v_bitop3_b32 v17, v18, v4, v17 bitop3:0xbe
    s_waitcnt vmcnt(4)
    v_smfmac_f32_16x16x64_bf16 v[30:33], v[106:109], v[146:153], v5 abid:1
    v_perm_b32 v18, v147, v146, s46
    v_bitop3_b32 v17, v18, v4, v17 bitop3:0xbe
    v_perm_b32 v18, v151, v150, s46
    v_bitop3_b32 v17, v18, v4, v17 bitop3:0xbe
    s_waitcnt vmcnt(2)
    v_smfmac_f32_16x16x64_bf16 v[30:33], v[110:113], v[154:161], v5 abid:1
    v_perm_b32 v18, v155, v154, s46
    v_bitop3_b32 v17, v18, v4, v17 bitop3:0xbe
    v_perm_b32 v18, v159, v158, s46
    v_bitop3_b32 v17, v18, v4, v17 bitop3:0xbe
    s_waitcnt vmcnt(0)
    v_smfmac_f32_16x16x64_bf16 v[30:33], v[114:117], v[162:169], v5 abid:1
    v_perm_b32 v18, v163, v162, s46
    v_bitop3_b32 v17, v18, v4, v17 bitop3:0xbe
    v_perm_b32 v18, v167, v166, s46
    v_bitop3_b32 v17, v18, v4, v17 bitop3:0xbe
    v_cmp_ne_u32 vcc, 0, v17
    s_cbranch_vccz L_ospin_ok
    s_add_u32 s68, s68, 1
    s_max_u32 s66, s68, 5
    s_bitcmp1_b32 s66, 0
    s_cselect_b32 s66, 1310720, 0
    s_add_u32 s66, s30, s66
    s_addc_u32 s67, s31, 0
    s_cmp_eq_u32 s68, 3
    s_cbranch_scc0 L_ospin_nb
    v_mov_b32 v18, 18176
    ds_write_b32 v18, v18
    s_waitcnt lgkmcnt(0)
    s_barrier
L_ospin_nb:
    s_add_u32 s53, s53, 1
    s_cmp_lt_u32 s53, 0x40000
    s_cbranch_scc1 L_ospin
L_ospin_ok:
    s_nop 1
    v_cvt_pk_bf16_f32 v30, v30, 0
    v_cvt_pk_bf16_f32 v31, v31, 0
    v_cvt_pk_bf16_f32 v32, v32, 0
    v_cvt_pk_bf16_f32 v33, v33, 0
    s_bfm_b64 exec, 32, 0
    ds_write_b128 v13, v[30:33] offset:8192
    s_mov_b64 exec, -1
    ds_read_b128 v[102:105], v14 offset:8192
    ds_read_b128 v[106:109], v14 offset:8256
    ds_read_b128 v[110:113], v14 offset:8320
    ds_read_b128 v[114:117], v14 offset:8384
    ds_read_b128 v[118:121], v14 offset:8448
    ds_read_b128 v[122:125], v14 offset:8512
    ds_read_b128 v[126:129], v14 offset:8576
    ds_read_b128 v[130:133], v14 offset:8640
    s_cmp_ge_u32 s68, 3
    s_cbranch_scc1 L_ospin_bbx
    s_barrier
L_ospin_bbx:
    s_waitcnt lgkmcnt(7)
    v_smfmac_f32_16x16x64_bf16 v[34:37], v[102:105], v[170:177], v5
    s_waitcnt lgkmcnt(6)
    v_smfmac_f32_16x16x64_bf16 v[34:37], v[106:109], v[178:185], v5
    s_waitcnt lgkmcnt(5)
    v_smfmac_f32_16x16x64_bf16 v[34:37], v[110:113], v[186:193], v5
    s_waitcnt lgkmcnt(4)
    v_smfmac_f32_16x16x64_bf16 v[34:37], v[114:117], v[194:201], v5
    s_waitcnt lgkmcnt(3)
    v_smfmac_f32_16x16x64_bf16 v[34:37], v[118:121], v[202:209], v5
    s_waitcnt lgkmcnt(2)
    v_smfmac_f32_16x16x64_bf16 v[34:37], v[122:125], v[210:217], v5
    s_waitcnt lgkmcnt(1)
    v_smfmac_f32_16x16x64_bf16 v[34:37], v[126:129], v[218:225], v5
    s_waitcnt lgkmcnt(0)
    v_smfmac_f32_16x16x64_bf16 v[34:37], v[130:133], v[226:233], v5
    s_bfm_b64 exec, 16, 0
    s_nop 6
    ds_write_b128 v15, v[34:37] offset:0
    s_waitcnt lgkmcnt(0)
    s_barrier
    s_mov_b64 exec, -1
    s_branch L_fin
L_roleS:
    s_cmp_eq_u32 s41, 13
    s_cbranch_scc1 L_c3x
    s_bfm_b64 exec, 16, 16
    global_load_dword v7, v27, s[58:59]
    s_mov_b64 exec, -1
    s_cmp_eq_u32 s32, 3
    s_cbranch_scc0 L_c3x
    s_bfm_b64 exec, 32, 0
    global_load_dword v7, v27, s[58:59] offset:1024
    s_mov_b64 exec, -1
L_c3x:
    s_sub_u32 s44, 13, s41
    s_lshl2_add_u32 s44, s44, s37
    s_cmp_ge_u32 s44, 18
    s_cbranch_scc1 L_sg0
    s_cmp_ge_u32 s44, 9
    s_cselect_b32 s58, s22, s20
    s_cselect_b32 s59, s23, s21
    s_cselect_b32 s45, 9, 0
    s_sub_u32 s44, s44, s45
    s_lshl_b32 s44, s44, 6
    v_add_u32 v8, s44, v1
    v_mul_u32_u24 v9, 7282, v8
    v_lshrrev_b32 v9, 16, v9
    v_lshrrev_b32 v10, 3, v9
    v_mul_u32_u24 v10, 589824, v10
    v_mul_u32_u24 v9, 8064, v9
    v_lshl_add_u32 v8, v8, 7, v9
    s_mul_i32 s45, s32, 1152
    s_add_u32 s45, s45, 516096
    v_add3_u32 v8, v8, v10, s45
    global_load_dword v7, v8, s[58:59]
L_sg0:
    s_sub_u32 s44, 13, s41
    s_lshl2_add_u32 s44, s44, s37
    s_cmp_ge_u32 s44, 18
    s_cbranch_scc1 L_sg1
    s_cmp_ge_u32 s44, 9
    s_cselect_b32 s58, s22, s20
    s_cselect_b32 s59, s23, s21
    s_cselect_b32 s45, 9, 0
    s_sub_u32 s44, s44, s45
    s_lshl_b32 s44, s44, 6
    v_add_u32 v8, s44, v1
    v_mul_u32_u24 v9, 7282, v8
    v_lshrrev_b32 v9, 16, v9
    v_lshrrev_b32 v10, 3, v9
    v_mul_u32_u24 v10, 589824, v10
    v_mul_u32_u24 v9, 8064, v9
    v_lshl_add_u32 v8, v8, 7, v9
    s_mul_i32 s45, s32, 1152
    s_add_u32 s45, s45, 589824
    v_add3_u32 v8, v8, v10, s45
    global_load_dword v7, v8, s[58:59]
L_sg1:
    s_sub_u32 s44, s41, 9
    s_lshl2_add_u32 s44, s44, s37
    s_lshl_b32 s44, s44, 13
    s_mul_i32 s45, s32, 663552
    s_add_u32 s44, s44, s45
    v_lshl_add_u32 v8, v1, 7, s44
    global_load_dword v7, v8, s[24:25]
    s_branch L_fin
L_roleF:
    s_add_u32 m0, s55, 0
    s_nop 0
    global_load_lds_dwordx4 v[20:21], off
    v_lshl_add_u64 v[20:21], s[62:63], 0, v[20:21]
    s_mul_i32 s44, s37, 36
    s_mul_i32 s45, s43, 18
    s_mul_i32 s46, s37, 640
    v_lshrrev_b32 v16, 5, v1
    v_and_b32 v11, 31, v0
    v_add_u32 v12, s44, v11
    v_lshlrev_b32 v13, 3, v12
    v_lshl_add_u32 v13, v16, 2, v13
    global_load_dword v51, v13, s[8:9]
    v_lshrrev_b32 v13, 4, v12
    v_and_b32 v12, 15, v12
    v_lshlrev_b32 v12, 4, v12
    v_lshl_add_u32 v12, v13, 11, v12
    v_lshl_add_u32 v12, v16, 10, v12
    v_add_u32 v9, 524288, v12
    v_add_u32 v11, s45, v11
    v_subrev_u32 v12, 36, v11
    v_min_u32 v11, v11, v12
    v_lshl_add_u32 v11, v11, 4, s46
    v_lshl_add_u32 v8, v16, 3, v11
    v_and_or_b32 v11, v0, 3, 32
    v_add_u32 v12, s44, v11
    v_lshlrev_b32 v13, 3, v12
    v_lshl_add_u32 v13, v2, 1, v13
    global_load_ushort v52, v13, s[8:9]
    v_lshrrev_b32 v13, 4, v12
    v_and_b32 v12, 15, v12
    v_lshlrev_b32 v12, 4, v12
    v_lshl_add_u32 v12, v13, 11, v12
    v_lshrrev_b32 v13, 3, v1
    v_lshl_add_u32 v12, v13, 8, v12
    v_add_u32 v27, 524288, v12
    v_add_u32 v11, s45, v11
    v_subrev_u32 v12, 36, v11
    v_min_u32 v11, v11, v12
    v_lshl_add_u32 v11, v11, 4, s46
    v_lshl_add_u32 v24, v2, 2, v11
    s_lshl_b32 s44, s37, 3
    v_lshl_add_u32 v23, v16, 2, s44
    v_lshl_add_u32 v10, v2, 4, s46
    v_bfe_u32 v16, v0, 2, 2
    v_mov_b32 v11, 3072
    v_cmp_eq_u32 vcc, 1, v16
    s_nop 1
    v_cndmask_b32 v10, v10, v11, vcc
    s_lshl_b32 s44, s37, 9
    v_add_u32 v11, s44, v6
    s_lshl_b32 s44, s37, 10
    s_add_u32 s44, s44, 12288
    v_lshl_add_u32 v12, v1, 3, s44
    v_and_b32 v13, 1, v16
    v_lshl_add_u32 v13, v13, 8, s44
    v_lshl_add_u32 v13, v2, 4, v13
    v_lshrrev_b32 v16, 1, v16
    v_lshl_add_u32 v13, v16, 6, v13
    s_min_u32 s46, s37, 2
    s_mul_i32 s44, s42, 36864
    s_mul_i32 s45, s46, 384
    s_add_u32 s44, s44, s45
    v_and_b32 v22, 0x70, v6
    v_mul_u32_u24 v14, 1152, v2
    v_add3_u32 v14, v14, v22, s44
    v_mul_u32_u24 v26, 9216, v16
    v_sub_u32 v15, v14, v26
    v_add_u32 v15, 9216, v15
    v_add_u32 v14, v14, v26
    v_cmp_gt_u32 vcc, 32, v1
    s_nop 1
    v_cndmask_b32 v16, 2, v16, vcc
    v_bfe_u32 v26, v0, 2, 1
    v_lshl_add_u32 v16, v16, 1, v26
    s_mul_i32 s44, s46, 110592
    s_lshl_b32 s45, s42, 7
    s_add_u32 s44, s44, s45
    s_add_u32 s44, s44, 589824
    v_and_b32 v22, 3, v0
    v_lshl_add_u32 v22, v22, 4, s44
    v_and_b32 v26, 16, v0
    v_lshl_add_u32 v22, v26, 2, v22
    s_movk_i32 s45, 18432
    v_mad_u32_u24 v22, v16, s45, v22
    s_mov_b32 s68, 0
    s_mov_b32 s60, 0x00ff00ff
    s_mov_b32 s61, 0xff00ff00
    v_mov_b32 v38, 0
    v_mov_b32 v39, 0
    v_mov_b32 v40, 0
    v_mov_b32 v41, 0
    v_mov_b32 v42, 0
    v_mov_b32 v43, 0
    v_mov_b32 v44, 0
    v_mov_b32 v45, 0
    s_mov_b32 s58, 0x000f000f
    s_mov_b32 s59, 0x000f000f
    v_mov_b32 v30, 0
    v_mov_b32 v31, 0
    v_mov_b32 v32, 0
    v_mov_b32 v33, 0
    v_mov_b32 v34, 0
    v_mov_b32 v35, 0
    v_mov_b32 v36, 0
    v_mov_b32 v37, 0
    s_waitcnt vmcnt(5)
    s_add_u32 m0, s55, 1024
    s_nop 0
    global_load_lds_dwordx4 v[20:21], off
    v_lshl_add_u64 v[20:21], s[62:63], 0, v[20:21]
    s_waitcnt vmcnt(5)
    s_add_u32 m0, s55, 2048
    s_nop 0
    global_load_lds_dwordx4 v[20:21], off
    v_lshl_add_u64 v[20:21], s[62:63], 0, v[20:21]
    s_waitcnt vmcnt(5)
    s_add_u32 m0, s55, 3072
    s_nop 0
    global_load_lds_dwordx4 v[20:21], off
    v_lshl_add_u64 v[20:21], s[62:63], 0, v[20:21]
    s_waitcnt vmcnt(5)
    ds_read_b64 v[170:171], v25 offset:0
    ds_read_b64 v[172:173], v25 offset:512
    s_add_u32 m0, s55, 4096
    s_nop 0
    global_load_lds_dwordx4 v[20:21], off
    v_lshl_add_u64 v[20:21], s[62:63], 0, v[20:21]
    s_waitcnt vmcnt(3)
    ds_read_b64 v[174:175], v25 offset:1024
    ds_read_b64 v[176:177], v25 offset:1536
    s_add_u32 m0, s55, 5120
    s_nop 0
    global_load_lds_dwordx4 v[20:21], off
    v_lshl_add_u64 v[20:21], s[62:63], 0, v[20:21]
    s_waitcnt vmcnt(3)
    ds_read_b64 v[178:179], v25 offset:2048
    ds_read_b64 v[180:181], v25 offset:2560
    s_add_u32 m0, s55, 6144
    s_nop 0
    global_load_lds_dwordx4 v[20:21], off
    v_lshl_add_u64 v[20:21], s[62:63], 0, v[20:21]
    s_waitcnt vmcnt(3)
    ds_read_b64 v[182:183], v25 offset:3072
    ds_read_b64 v[184:185], v25 offset:3584
    s_add_u32 m0, s55, 7168
    s_nop 0
    global_load_lds_dwordx4 v[20:21], off
    v_lshl_add_u64 v[20:21], s[62:63], 0, v[20:21]
    s_waitcnt vmcnt(3)
    ds_read_b64 v[186:187], v25 offset:4096
    ds_read_b64 v[188:189], v25 offset:4608
    s_add_u32 m0, s55, 8192
    s_nop 0
    global_load_lds_dwordx4 v[20:21], off
    v_lshl_add_u64 v[20:21], s[64:65], 0, v[20:21]
    s_waitcnt vmcnt(3)
    ds_read_b64 v[190:191], v25 offset:5120
    ds_read_b64 v[192:193], v25 offset:5632
    s_add_u32 m0, s55, 9216
    s_nop 0
    global_load_lds_dwordx4 v[20:21], off
    v_lshl_add_u64 v[20:21], s[62:63], 0, v[20:21]
    s_waitcnt vmcnt(3)
    ds_read_b64 v[194:195], v25 offset:6144
    ds_read_b64 v[196:197], v25 offset:6656
    s_add_u32 m0, s55, 10240
    s_nop 0
    global_load_lds_dwordx4 v[20:21], off
    v_lshl_add_u64 v[20:21], s[62:63], 0, v[20:21]
    s_waitcnt vmcnt(3)
    ds_read_b64 v[198:199], v25 offset:7168
    ds_read_b64 v[200:201], v25 offset:7680
    s_add_u32 m0, s55, 11264
    s_nop 0
    global_load_lds_dwordx4 v[20:21], off
    v_lshl_add_u64 v[20:21], s[62:63], 0, v[20:21]
    s_waitcnt vmcnt(3)
    ds_read_b64 v[202:203], v25 offset:8192
    ds_read_b64 v[204:205], v25 offset:8704
    s_add_u32 m0, s55, 12288
    s_nop 0
    global_load_lds_dwordx4 v[20:21], off
    v_lshl_add_u64 v[20:21], s[62:63], 0, v[20:21]
    s_waitcnt vmcnt(3)
    ds_read_b64 v[206:207], v25 offset:9216
    ds_read_b64 v[208:209], v25 offset:9728
    s_add_u32 m0, s55, 13312
    s_nop 0
    global_load_lds_dwordx4 v[20:21], off
    v_lshl_add_u64 v[20:21], s[62:63], 0, v[20:21]
    s_waitcnt vmcnt(3)
    ds_read_b64 v[210:211], v25 offset:10240
    ds_read_b64 v[212:213], v25 offset:10752
    s_add_u32 m0, s55, 14336
    s_nop 0
    global_load_lds_dwordx4 v[20:21], off
    v_lshl_add_u64 v[20:21], s[62:63], 0, v[20:21]
    s_waitcnt vmcnt(3)
    ds_read_b64 v[214:215], v25 offset:11264
    ds_read_b64 v[216:217], v25 offset:11776
    s_add_u32 m0, s55, 15360
    s_nop 0
    global_load_lds_dwordx4 v[20:21], off
    v_lshl_add_u64 v[20:21], s[62:63], 0, v[20:21]
    s_waitcnt vmcnt(15)
    v_lshlrev_b32 v50, 16, v51
    v_and_b32 v51, s54, v51
    v_lshlrev_b32 v52, 16, v52
    s_movk_i32 s44, 0x3f80
    global_load_dwordx4 v[154:157], v27, s[30:31] sc1
    global_load_dwordx4 v[138:141], v9, s[30:31] offset:0 sc1
    global_load_dwordx4 v[142:145], v9, s[30:31] offset:256 sc1
    global_load_dwordx4 v[146:149], v9, s[30:31] offset:512 sc1
    global_load_dwordx4 v[150:153], v9, s[30:31] offset:768 sc1
    s_add_u32 m0, s55, 16384
    s_nop 0
    global_load_lds_dwordx4 v[20:21], off
    v_lshl_add_u64 v[20:21], s[62:63], 0, v[20:21]
    s_add_u32 m0, s55, 17408
    s_nop 0
    global_load_lds_dwordx4 v[20:21], off
    s_waitcnt vmcnt(10)
    ds_read_b64 v[218:219], v25 offset:12288
    ds_read_b64 v[220:221], v25 offset:12800
    s_waitcnt vmcnt(9)
    ds_read_b64 v[222:223], v25 offset:13312
    ds_read_b64 v[224:225], v25 offset:13824
    s_waitcnt vmcnt(8)
    ds_read_b64 v[226:227], v25 offset:14336
    ds_read_b64 v[228:229], v25 offset:14848
    s_waitcnt vmcnt(7)
    ds_read_b64 v[230:231], v25 offset:15360
    ds_read_b64 v[232:233], v25 offset:15872
    s_branch L_hsum
L_hspin:
    global_load_dwordx4 v[154:157], v27, s[30:31] sc1
    global_load_dwordx4 v[138:141], v9, s[30:31] offset:0 sc1
    global_load_dwordx4 v[142:145], v9, s[30:31] offset:256 sc1
    global_load_dwordx4 v[146:149], v9, s[30:31] offset:512 sc1
    global_load_dwordx4 v[150:153], v9, s[30:31] offset:768 sc1
    s_waitcnt vmcnt(0)
L_hsum:
    s_waitcnt vmcnt(6)
    v_perm_b32 v18, v155, v154, s52
    v_perm_b32 v19, v157, v156, s52
    v_lshl_or_b32 v18, v19, 16, v18
    v_xor_b32 v17, v18, v4
    v_permlane32_swap_b32 v154, v156
    v_permlane32_swap_b32 v155, v157
    v_pk_add_f32 v[154:155], v[154:155], v[156:157]
    s_waitcnt vmcnt(5)
    v_perm_b32 v18, v139, v138, s52
    v_perm_b32 v19, v141, v140, s52
    v_lshl_or_b32 v18, v19, 16, v18
    v_bitop3_b32 v17, v18, v4, v17 bitop3:0xbe
    v_permlane16_swap_b32 v154, v155
    v_add_f32 v154, v154, v155
    s_waitcnt vmcnt(4)
    v_pk_add_f32 v[46:47], v[138:139], v[142:143]
    v_pk_add_f32 v[48:49], v[140:141], v[144:145]
    v_add_f32_dpp v154, v154, v154 row_ror:8 row_mask:0xf bank_mask:0xf
    v_perm_b32 v18, v143, v142, s52
    v_perm_b32 v19, v145, v144, s52
    v_lshl_or_b32 v18, v19, 16, v18
    v_bitop3_b32 v17, v18, v4, v17 bitop3:0xbe
    v_add_f32 v154, v154, v52
    v_cvt_pk_bf16_f32 v154, v154, 0
    ds_write_b32 v24, v154 offset:8192
    s_waitcnt vmcnt(3)
    v_pk_add_f32 v[46:47], v[46:47], v[146:147]
    v_pk_add_f32 v[48:49], v[48:49], v[148:149]
    v_perm_b32 v18, v147, v146, s52
    v_perm_b32 v19, v149, v148, s52
    v_lshl_or_b32 v18, v19, 16, v18
    v_bitop3_b32 v17, v18, v4, v17 bitop3:0xbe
    s_waitcnt vmcnt(2)
    v_pk_add_f32 v[46:47], v[46:47], v[150:151]
    v_pk_add_f32 v[48:49], v[48:49], v[152:153]
    v_perm_b32 v18, v151, v150, s52
    v_perm_b32 v19, v153, v152, s52
    v_permlane32_swap_b32 v46, v48
    v_permlane32_swap_b32 v47, v49
    v_pk_add_f32 v[46:47], v[46:47], v[50:51]
    v_pk_add_f32 v[46:47], v[46:47], v[48:49]
    v_cvt_pk_bf16_f32 v46, v46, 0
    v_cvt_pk_bf16_f32 v47, v47, 0
    ds_write_b64 v8, v[46:47] offset:8192
    ds_read_b128 v[102:105], v10 offset:8192
    ds_read_b128 v[106:109], v10 offset:8256
    ds_read_b128 v[110:113], v10 offset:8320
    ds_read_b128 v[114:117], v10 offset:8384
    ds_read_b128 v[118:121], v10 offset:8448
    ds_read_b128 v[122:125], v10 offset:8512
    ds_read_b128 v[126:129], v10 offset:8576
    ds_read_b128 v[130:133], v10 offset:8640
    ds_read_b128 v[134:137], v10 offset:8704
    v_lshl_or_b32 v18, v19, 16, v18
    v_bitop3_b32 v17, v18, v4, v17 bitop3:0xbe
    v_cmp_ne_u32 vcc, 0, v17
    s_cbranch_vccz L_hspin_ok
    s_add_u32 s68, s68, 1
    s_cmp_eq_u32 s68, 3
    s_cbranch_scc0 L_hspin_nb
    v_mov_b32 v18, 18176
    ds_write_b32 v18, v18
    s_waitcnt lgkmcnt(0)
    s_barrier
L_hspin_nb:
    s_add_u32 s53, s53, 1
    s_cmp_lt_u32 s53, 0x40000
    s_cbranch_scc1 L_hspin
L_hspin_ok:
    v_cndmask_b32 v154, 0, v154, s[58:59]
    v_dot2_f32_bf16 v16, v46, s44, 0
    v_dot2_f32_bf16 v17, v46, v46, 0
    v_dot2_f32_bf16 v16, v47, s44, v16
    v_dot2_f32_bf16 v17, v47, v47, v17
    v_dot2_f32_bf16 v16, v154, s44, v16
    v_dot2_f32_bf16 v17, v154, v154, v17
    s_waitcnt lgkmcnt(8)
    v_smfmac_f32_16x16x64_bf16 v[30:33], v[102:105], v[170:177], v5
    s_waitcnt lgkmcnt(7)
    v_smfmac_f32_16x16x64_bf16 v[30:33], v[106:109], v[178:185], v5
    v_permlane32_swap_b32 v16, v17
    s_waitcnt lgkmcnt(6)
    v_smfmac_f32_16x16x64_bf16 v[30:33], v[110:113], v[186:193], v5
    v_add_f32 v16, v16, v17
    v_mov_b32 v17, v16
    s_waitcnt lgkmcnt(5)
    v_smfmac_f32_16x16x64_bf16 v[30:33], v[114:117], v[194:201], v5
    v_permlane16_swap_b32 v16, v17
    s_waitcnt lgkmcnt(4)
    v_smfmac_f32_16x16x64_bf16 v[30:33], v[118:121], v[202:209], v5
    v_add_f32 v16, v16, v17
    s_waitcnt lgkmcnt(3)
    v_smfmac_f32_16x16x64_bf16 v[30:33], v[122:125], v[210:217], v5
    v_add_f32_dpp v16, v16, v16 row_ror:8 row_mask:0xf bank_mask:0xf
    s_waitcnt vmcnt(1)
    ds_read_b64 v[234:235], v25 offset:16384
    ds_read_b64 v[236:237], v25 offset:16896
    s_waitcnt vmcnt(0)
    ds_read_b64 v[238:239], v25 offset:17408
    ds_read_b64 v[240:241], v25 offset:17920
    s_cmp_eq_u32 s37, 3
    s_cbranch_scc1 L_nod0
    global_load_dwordx4 v[54:57], v14, s[24:25] offset:0
    global_load_dwordx4 v[70:73], v15, s[24:25] offset:128
    global_load_dwordx4 v[86:89], v14, s[24:25] offset:256
    v_add_u32 v14, 4608, v14
    v_add_u32 v15, 4608, v15
    global_load_dwordx4 v[58:61], v14, s[24:25] offset:0
    global_load_dwordx4 v[74:77], v15, s[24:25] offset:128
    global_load_dwordx4 v[90:93], v14, s[24:25] offset:256
    v_add_u32 v14, 13824, v14
    v_add_u32 v15, 13824, v15
L_nod0:
    s_waitcnt lgkmcnt(6)
    v_smfmac_f32_16x16x64_bf16 v[30:33], v[126:129], v[218:225], v5
    v_add_f32_dpp v16, v16, v16 row_ror:4 row_mask:0xf bank_mask:0xf
    s_waitcnt lgkmcnt(5)
    v_smfmac_f32_16x16x64_bf16 v[30:33], v[130:133], v[226:233], v5
    v_add_f32_dpp v16, v16, v16 row_ror:2 row_mask:0xf bank_mask:0xf
    s_waitcnt lgkmcnt(0)
    v_smfmac_f32_16x16x64_bf16 v[30:33], v[134:137], v[234:241], v5
    v_add_f32_dpp v16, v16, v16 row_ror:1 row_mask:0xf bank_mask:0xf
    s_cmp_ge_u32 s68, 3
    s_cbranch_scc1 L_hspin_bbx
    s_barrier
L_hspin_bbx:
    ds_write_b32 v23, v16 offset:3136
    v_lshlrev_b32 v16, 2, v1
    v_mov_b32 v17, 0
    s_cmp_eq_u32 s37, 3
    s_bfm_b64 exec, 32, 0
    ds_write_b128 v11, v[30:33] offset:0
    s_mov_b64 exec, -1
    s_cmp_eq_u32 s37, 3
    s_cbranch_scc1 L_nod2
    global_load_dwordx4 v[62:65], v14, s[24:25] offset:0
    global_load_dwordx4 v[78:81], v15, s[24:25] offset:128
    global_load_dwordx4 v[94:97], v14, s[24:25] offset:256
    v_add_u32 v14, 4608, v14
    v_add_u32 v15, 4608, v15
    global_load_dwordx4 v[66:69], v14, s[24:25] offset:0
    global_load_dwordx4 v[82:85], v15, s[24:25] offset:128
    global_load_dwordx4 v[98:101], v14, s[24:25] offset:256
L_nod2:
    s_waitcnt lgkmcnt(0)
    s_barrier
    s_cbranch_scc1 L_fin
    ds_read_b128 v[146:149], v17 offset:3136
    ds_read_b128 v[150:153], v17 offset:3152
    ds_read2st64_b32 v[138:139], v16 offset0:0 offset1:1
    ds_read2st64_b32 v[140:141], v16 offset0:2 offset1:3
    ds_read2st64_b32 v[142:143], v16 offset0:4 offset1:5
    ds_read2st64_b32 v[144:145], v16 offset0:6 offset1:7
    s_mov_b32 s44, 0x3ae38e39
    s_mov_b32 s45, 0xbdd2d3e8
    v_mov_b32 v18, 0xc0135761
    v_mov_b32 v19, 0x3727c5ac
    s_waitcnt lgkmcnt(4)
    v_pk_add_f32 v[146:147], v[146:147], v[150:151]
    v_pk_add_f32 v[148:149], v[148:149], v[152:153]
    v_pk_add_f32 v[146:147], v[146:147], v[148:149]
    v_mul_f32 v146, s44, v146
    v_mul_f32 v147, s44, v147
    v_fma_f32 v147, -v146, v146, v147
    v_max_f32 v147, 0, v147
    v_add_f32 v147, v147, v19
    v_rsq_f32 v147, v147
    s_waitcnt lgkmcnt(0)
    v_pk_add_f32 v[138:139], v[138:139], v[142:143]
    v_pk_add_f32 v[140:141], v[140:141], v[144:145]
    v_pk_add_f32 v[138:139], v[138:139], v[140:141]
    v_fma_f32 v138, -v146, v139, v138
    v_mul_f32 v138, v138, v147
    v_mul_f32 v140, v138, v138
    v_fma_f32 v140, v140, s45, v18
    v_mul_f32 v140, v140, v138
    v_exp_f32 v140, v140
    v_permlane32_swap_b32 v138, v139
    v_add_f32 v140, 1.0, v140
    v_rcp_f32 v140, v140
    v_mul_f32 v138, v138, v139
    v_mul_f32 v138, v138, v140
    v_cvt_pk_bf16_f32 v138, v138, 0
    s_bfm_b64 exec, 32, 0
    ds_write2_b32 v12, v138, v138 offset0:0 offset1:65
    s_mov_b64 exec, -1
    ds_read_b128 v[102:105], v13 offset:0
    ds_read_b128 v[106:109], v13 offset:128
    s_waitcnt vmcnt(6) lgkmcnt(1)
    v_smfmac_f32_16x16x64_bf16 v[34:37], v[102:105], v[54:61], v5
    v_smfmac_f32_16x16x64_bf16 v[38:41], v[102:105], v[70:77], v5
    v_smfmac_f32_16x16x64_bf16 v[42:45], v[102:105], v[86:93], v5
    s_waitcnt vmcnt(0) lgkmcnt(0)
    v_smfmac_f32_16x16x64_bf16 v[34:37], v[106:109], v[62:69], v5
    v_smfmac_f32_16x16x64_bf16 v[38:41], v[106:109], v[78:85], v5
    v_smfmac_f32_16x16x64_bf16 v[42:45], v[106:109], v[94:101], v5
    s_lshr_b32 s44, s42, 3
    s_mul_i32 s44, s44, 18432
    s_bfe_u32 s45, s42, 0x20001
    s_lshl4_add_u32 s44, s45, s44
    s_and_b32 s45, s42, 1
    s_lshl_b32 s45, s45, 6
    s_add_u32 s44, s44, s45
    s_add_u32 s44, s44, 589824
    v_lshl_add_u32 v8, v1, 7, s44
    v_cndmask_b32 v34, v38, v34, s[60:61]
    v_cndmask_b32 v35, v39, v35, s[60:61]
    v_cndmask_b32 v36, v40, v36, s[60:61]
    v_cndmask_b32 v37, v41, v37, s[60:61]
    v_permlane32_swap_b32 v34, v42
    v_permlane32_swap_b32 v35, v43
    v_permlane32_swap_b32 v36, v44
    v_permlane32_swap_b32 v37, v45
    v_add_f32_dpp v34, v42, v34 row_ror:8 row_mask:0xf bank_mask:0xf
    v_add_f32_dpp v35, v43, v35 row_ror:8 row_mask:0xf bank_mask:0xf
    v_add_f32_dpp v36, v44, v36 row_ror:8 row_mask:0xf bank_mask:0xf
    v_add_f32_dpp v37, v45, v37 row_ror:8 row_mask:0xf bank_mask:0xf
    s_mov_b32 exec_hi, 0x00ff00ff
    v_perm_b32 v34, v34, v4, s48
    v_perm_b32 v35, v35, v4, s49
    v_perm_b32 v36, v36, v4, s50
    v_perm_b32 v37, v37, v4, s51
    global_store_dwordx4 v22, v[34:37], s[30:31] sc1
    s_mov_b64 exec, -1
    s_cmp_eq_u32 s37, 0
    s_cbranch_scc0 L_fin
    v_add_u32 v9, 6144, v8
    v_add_u32 v10, 12288, v8
    s_mul_i32 s44, s42, 1821
    s_lshr_b32 s44, s44, 16
    s_mul_i32 s45, s44, 36
    s_sub_u32 s45, s42, s45
    s_mul_i32 s46, s43, 18
    s_add_u32 s45, s45, s46
    s_sub_u32 s46, s45, 36
    s_min_u32 s45, s45, s46
    s_mul_i32 s44, s44, 640
    s_lshl4_add_u32 s44, s45, s44
    v_lshl_add_u32 v11, v2, 2, s44
    ds_read_b32 v12, v11 offset:8192
    s_lshl_b32 s44, s42, 3
    v_lshl_add_u32 v11, v2, 1, s44
    v_mov_b32 v46, 0
    v_mov_b32 v47, 0
    v_mov_b32 v48, 0
    v_mov_b32 v49, 0
    s_waitcnt lgkmcnt(0)
    v_lshlrev_b32 v12, 16, v12
    s_bfm_b64 exec, 48, 0
    s_waitcnt vmcnt(0)
L_rspin:
    global_load_dwordx4 v[138:141], v8, s[30:31] sc1
    global_load_dwordx4 v[142:145], v9, s[30:31] sc1
    global_load_dwordx4 v[146:149], v10, s[30:31] sc1
    s_waitcnt vmcnt(2)
    v_perm_b32 v18, v139, v138, s52
    v_perm_b32 v19, v141, v140, s52
    v_lshl_or_b32 v18, v19, 16, v18
    v_xor_b32 v17, v18, v4
    s_waitcnt vmcnt(1)
    v_pk_add_f32 v[46:47], v[138:139], v[142:143]
    v_pk_add_f32 v[48:49], v[140:141], v[144:145]
    v_perm_b32 v18, v143, v142, s52
    v_perm_b32 v19, v145, v144, s52
    v_lshl_or_b32 v18, v19, 16, v18
    v_bitop3_b32 v17, v18, v4, v17 bitop3:0xbe
    s_waitcnt vmcnt(0)
    v_pk_add_f32 v[46:47], v[46:47], v[146:147]
    v_pk_add_f32 v[48:49], v[48:49], v[148:149]
    v_perm_b32 v18, v147, v146, s52
    v_perm_b32 v19, v149, v148, s52
    v_lshl_or_b32 v18, v19, 16, v18
    v_bitop3_b32 v17, v18, v4, v17 bitop3:0xbe
    v_cmp_ne_u32 vcc, 0, v17
    s_cbranch_vccz L_rspin_ok
    s_mov_b64 exec, vcc
    s_add_u32 s53, s53, 1
    s_cmp_lt_u32 s53, 0x40000
    s_cbranch_scc1 L_rspin
L_rspin_ok:
    s_mov_b64 exec, -1
    v_permlane32_swap_b32 v46, v48
    v_permlane32_swap_b32 v47, v49
    v_pk_add_f32 v[46:47], v[46:47], v[48:49]
    s_nop 1
    v_permlane16_swap_b32 v46, v47
    v_add_f32 v46, v46, v47
    s_nop 1
    v_add_f32_dpp v46, v46, v46 row_ror:8 row_mask:0xf bank_mask:0xf
    s_nop 1
    v_add_f32_dpp v46, v46, v46 row_ror:4 row_mask:0xf bank_mask:0xf
    s_nop 1
    v_add_f32_dpp v46, v46, v46 row_ror:2 row_mask:0xf bank_mask:0xf
    s_nop 1
    v_add_f32_dpp v46, v46, v46 row_ror:1 row_mask:0xf bank_mask:0xf
    v_cvt_pk_bf16_f32 v46, 0, v46
    v_add_f32 v46, v46, v12
    v_cvt_pk_bf16_f32 v46, v46, 0
    s_mov_b32 exec_lo, 0x00010001
    s_mov_b32 exec_hi, 0x00010001
    global_store_short v11, v46, s[26:27]
    s_cmp_eq_u32 s42, 0
    s_cbranch_scc0 L_fin0
    s_bfm_b64 exec, 1, 0
    v_mov_b32 v8, 0
    global_store_dword v8, v4, s[30:31]
L_fin0:
    s_mov_b64 exec, -1
    s_branch L_fin
L_toucher:
    s_lshl_b32 s44, s32, 5
    s_add_u32 s44, s44, s33
    s_lshl_b32 s44, s44, 9
    s_add_u32 s44, s44, 1314816
    s_waitcnt lgkmcnt(0)
    s_add_u32 s58, s30, s44
    s_addc_u32 s59, s31, 0
    s_load_dword s45, s[58:59], 0
    s_load_dword s45, s[58:59], 64
    s_load_dword s45, s[58:59], 128
    s_load_dword s45, s[58:59], 192
    s_load_dword s45, s[58:59], 256
    s_load_dword s45, s[58:59], 320
    s_load_dword s45, s[58:59], 384
    s_load_dword s45, s[58:59], 448
    s_barrier
    s_barrier
    s_endpgm
L_helper:
    s_mov_b32 s37, 4
    v_lshrrev_b32 v14, 3, v1
    v_add_u32 v14, 1, v14
    v_cmp_gt_u32 vcc, 5, v14
    v_bfe_u32 v15, v0, 1, 2
    v_min_u32 v16, 1, v15
    v_cndmask_b32 v14, 0, v14, vcc
    v_lshl_add_u32 v15, v15, 2, v16
    v_add_u32 v14, v14, v15
    v_and_b32 v15, 1, v0
    v_lshl_add_u32 v14, v14, 1, v15
    s_lshr_b32 s44, s44, 4
    v_lshl_add_u32 v17, v14, 2, s44
    v_mov_b32 v18, v13
    s_lshl_b32 s47, s34, 9
    s_add_u32 s47, s47, 4096
    v_add_u32 v28, s47, v6
    s_add_u32 s66, s30, 1310720
    s_addc_u32 s67, s31, 0
    s_mov_b32 s68, 0
    v_mov_b32 v30, 0
    v_mov_b32 v31, 0
    v_mov_b32 v32, 0
    v_mov_b32 v33, 0
    ds_write_b128 v6, v[30:33] offset:12288
    ds_write_b128 v6, v[30:33] offset:13312
    ds_write_b128 v6, v[30:33] offset:14336
    ds_write_b128 v6, v[30:33] offset:15360
    ds_write_b128 v6, v[30:33] offset:16384
    ds_write_b128 v6, v[30:33] offset:17408
    v_mov_b32 v46, 0x3f80
    v_mov_b32 v47, 0x3f80
    v_mov_b32 v48, 0x3f80
    v_mov_b32 v49, 0x3f80
    ds_write_b128 v6, v[46:49] offset:11264
    s_mov_b32 s54, 0xffff0000
    s_mov_b32 s53, 0
    s_mov_b32 s48, 0x7060500
    s_mov_b32 s49, 0x7060501
    s_mov_b32 s50, 0x7060502
    s_mov_b32 s51, 0x7060503
    s_mov_b32 s52, 0x0c0c0400
    v_and_b32 v12, 3, v0
    v_and_b32 v13, 1, v0
    v_lshlrev_b32 v13, 17, v13
    v_or_b32 v12, v12, v13
    v_or_b32 v12, 0x10000, v12
    v_mul_u32_u24 v5, 0x5555, v12
    s_lshr_b32 s41, s33, 4
    s_mul_i32 s41, s41, 7
    s_add_u32 s41, s41, s36
    s_sub_u32 s41, s41, 9
    s_mul_i32 s42, s35, 9
    s_add_u32 s42, s42, s36
    s_cmp_lt_u32 s41, 9
    s_cselect_b32 s40, 1, 2
    s_cmp_lt_u32 s36, 9
    s_cselect_b32 s40, 0, s40
    s_and_b32 s43, s42, 1
    v_bfe_u32 v8, v0, 2, 1
    v_mul_u32_u24 v8, 640, v8
    v_lshl_add_u32 v8, v2, 4, v8
    s_lshl_b32 s44, s37, 7
    v_add_u32 v8, s44, v8
    v_lshl_add_u32 v9, v3, 1, v2
    s_lshl_b32 s44, s37, 9
    v_lshl_add_u32 v9, v9, 4, s44
    s_waitcnt vmcnt(2)
    ds_write_b128 v6, v[50:53] offset:4096
    ds_write_b16 v18, v22 offset:5120
    ds_read_b32 v23, v17 offset:4096
    v_lshlrev_b32 v138, 16, v50
    v_and_b32 v139, s54, v50
    v_lshlrev_b32 v140, 16, v51
    v_and_b32 v141, s54, v51
    v_lshlrev_b32 v142, 16, v52
    v_and_b32 v143, s54, v52
    v_lshlrev_b32 v144, 16, v53
    v_and_b32 v145, s54, v53
    v_lshlrev_b32 v146, 16, v22
    v_add_f32 v12, v138, v139
    v_mul_f32 v13, v138, v138
    v_fmac_f32 v13, v139, v139
    v_add_f32 v12, v12, v140
    v_fmac_f32 v13, v140, v140
    v_add_f32 v12, v12, v141
    v_fmac_f32 v13, v141, v141
    v_add_f32 v12, v12, v142
    v_fmac_f32 v13, v142, v142
    v_add_f32 v12, v12, v143
    v_fmac_f32 v13, v143, v143
    v_add_f32 v12, v12, v144
    v_fmac_f32 v13, v144, v144
    v_add_f32 v12, v12, v145
    v_fmac_f32 v13, v145, v145
    v_add_f32 v12, v12, v146
    v_fmac_f32 v13, v146, v146
    s_nop 1
    v_permlane32_swap_b32 v12, v13
    v_add_f32 v12, v12, v13
    v_mov_b32 v14, v12
    s_nop 1
    v_permlane16_swap_b32 v12, v14
    v_add_f32 v12, v12, v14
    s_nop 1
    v_add_f32_dpp v12, v12, v12 row_ror:8 row_mask:0xf bank_mask:0xf
    s_nop 1
    v_add_f32_dpp v12, v12, v12 row_ror:4 row_mask:0xf bank_mask:0xf
    s_nop 1
    v_add_f32_dpp v12, v12, v12 row_ror:2 row_mask:0xf bank_mask:0xf
    s_nop 1
    v_add_f32_dpp v12, v12, v12 row_ror:1 row_mask:0xf bank_mask:0xf
    v_mul_f32 v46, 0x3ae38e39, v12
    v_mov_b32 v47, v46
    s_waitcnt lgkmcnt(0)
    v_lshlrev_b32 v14, 16, v23
    v_and_b32 v15, s54, v23
    v_permlane32_swap_b32 v46, v47
    v_fma_f32 v47, -v46, v46, v47
    v_max_f32 v47, 0, v47
    v_cvt_pk_bf16_f32 v47, 0, v47
    v_add_f32 v47, 0x3727c5ac, v47
    v_cvt_pk_bf16_f32 v47, 0, v47
    v_sqrt_f32 v47, v47
    v_cvt_pk_bf16_f32 v46, 0, v46
    v_cvt_pk_bf16_f32 v47, 0, v47
    v_rcp_f32 v47, v47
    v_sub_f32 v14, v14, v46
    v_sub_f32 v15, v15, v46
    v_cvt_pk_bf16_f32 v14, 0, v14
    v_cvt_pk_bf16_f32 v15, 0, v15
    v_mul_f32 v14, v14, v47
    v_mul_f32 v15, v15, v47
    v_cvt_pk_bf16_f32 v14, v14, 0
    v_cvt_pk_bf16_f32 v15, v15, 0
    v_add_u32 v16, 16384, v6
    s_bfm_b64 exec, 36, 0
    ds_write2_b32 v16, v14, v15 offset0:0 offset1:2
    ds_write2_b32 v16, v14, v15 offset0:161 offset1:163
    s_mov_b64 exec, -1
    ds_read_b128 v[102:105], v8 offset:16384
    s_waitcnt lgkmcnt(0)
    s_barrier
    s_add_u32 s38, s39, 0x01010101
    v_mov_b32 v4, s38
    s_waitcnt vmcnt(0)
    v_smfmac_f32_16x16x64_bf16 v[30:33], v[102:105], v[54:61], v5
    s_lshl_b32 s44, s35, 13
    s_add_u32 s44, s44, 4096
    v_lshrrev_b32 v10, 5, v1
    v_mul_u32_u24 v11, 3584, v10
    v_add3_u32 v11, v11, v6, s44
    v_lshlrev_b32 v12, 3, v1
    s_bfm_b64 exec, 32, 0
    s_nop 0
    ds_write_b128 v9, v[30:33] offset:0
    s_waitcnt lgkmcnt(0)
    s_barrier
    ds_read_b128 v[138:141], v6 offset:0
    ds_read_b128 v[142:145], v6 offset:512
    ds_read_b128 v[146:149], v6 offset:1024
    ds_read_b128 v[150:153], v6 offset:1536
    ds_read_b128 v[154:157], v6 offset:2048
    s_waitcnt lgkmcnt(3)
    v_pk_add_f32 v[38:39], v[138:139], v[142:143]
    v_pk_add_f32 v[40:41], v[140:141], v[144:145]
    s_waitcnt lgkmcnt(2)
    v_pk_add_f32 v[38:39], v[38:39], v[146:147]
    v_pk_add_f32 v[40:41], v[40:41], v[148:149]
    s_waitcnt lgkmcnt(1)
    v_pk_add_f32 v[38:39], v[38:39], v[150:151]
    v_pk_add_f32 v[40:41], v[40:41], v[152:153]
    s_waitcnt lgkmcnt(0)
    v_pk_add_f32 v[38:39], v[38:39], v[154:155]
    v_pk_add_f32 v[40:41], v[40:41], v[156:157]
    v_perm_b32 v38, v38, v4, s48
    v_perm_b32 v39, v39, v4, s49
    v_perm_b32 v40, v40, v4, s50
    v_perm_b32 v41, v41, v4, s51
    global_store_dwordx4 v28, v[38:41], s[66:67]
    s_mov_b64 exec, -1
    s_mul_i32 s44, s34, 1152
    s_add_u32 s44, s44, 196608
    v_add_u32 v24, s44, v6
    v_lshlrev_b32 v13, 4, v10
    s_add_u32 s58, s66, s44
    s_addc_u32 s59, s67, 0
    s_load_dword s56, s[58:59], 0
    s_load_dword s56, s[58:59], 64
    s_load_dword s56, s[58:59], 128
    s_load_dword s56, s[58:59], 192
    s_load_dword s56, s[58:59], 256
    s_load_dword s56, s[58:59], 320
    s_load_dword s56, s[58:59], 384
    s_load_dword s56, s[58:59], 448
    s_load_dword s56, s[58:59], 512
    s_load_dword s56, s[58:59], 576
    s_load_dword s56, s[58:59], 640
    s_load_dword s56, s[58:59], 704
    s_load_dword s56, s[58:59], 768
    s_load_dword s56, s[58:59], 832
    s_load_dword s56, s[58:59], 896
    s_load_dword s56, s[58:59], 960
    s_load_dword s56, s[58:59], 1024
    s_load_dword s56, s[58:59], 1088
    s_waitcnt vmcnt(0)
L_qspin:
    s_cmp_eq_u32 s68, 2
    s_cbranch_scc0 L_qnb
    s_bfm_b64 exec, 32, 0
    global_store_dwordx4 v28, v[38:41], s[30:31] sc1
    s_mov_b64 exec, -1
L_qnb:
    global_load_dwordx4 v[138:141], v11, s[66:67] offset:0 sc1
    global_load_dwordx4 v[142:145], v11, s[66:67] offset:512 sc1
    global_load_dwordx4 v[146:149], v11, s[66:67] offset:1024 sc1
    global_load_dwordx4 v[150:153], v11, s[66:67] offset:1536 sc1
    global_load_dwordx4 v[154:157], v11, s[66:67] offset:2048 sc1
    global_load_dwordx4 v[158:161], v11, s[66:67] offset:2560 sc1
    global_load_dwordx4 v[162:165], v11, s[66:67] offset:3072 sc1
    global_load_dwordx4 v[166:169], v11, s[66:67] offset:3584 sc1
    s_waitcnt vmcnt(7)
    v_perm_b32 v18, v139, v138, s52
    v_perm_b32 v19, v141, v140, s52
    v_lshl_or_b32 v18, v19, 16, v18
    v_xor_b32 v17, v18, v4
    s_waitcnt vmcnt(6)
    v_pk_add_f32 v[46:47], v[138:139], v[142:143]
    v_pk_add_f32 v[48:49], v[140:141], v[144:145]
    v_perm_b32 v18, v143, v142, s52
    v_perm_b32 v19, v145, v144, s52
    v_lshl_or_b32 v18, v19, 16, v18
    v_bitop3_b32 v17, v18, v4, v17 bitop3:0xbe
    s_waitcnt vmcnt(5)
    v_pk_add_f32 v[46:47], v[46:47], v[146:147]
    v_pk_add_f32 v[48:49], v[48:49], v[148:149]
    v_perm_b32 v18, v147, v146, s52
    v_perm_b32 v19, v149, v148, s52
    v_lshl_or_b32 v18, v19, 16, v18
    v_bitop3_b32 v17, v18, v4, v17 bitop3:0xbe
    s_waitcnt vmcnt(4)
    v_pk_add_f32 v[46:47], v[46:47], v[150:151]
    v_pk_add_f32 v[48:49], v[48:49], v[152:153]
    v_perm_b32 v18, v151, v150, s52
    v_perm_b32 v19, v153, v152, s52
    v_lshl_or_b32 v18, v19, 16, v18
    v_bitop3_b32 v17, v18, v4, v17 bitop3:0xbe
    s_waitcnt vmcnt(3)
    v_pk_add_f32 v[46:47], v[46:47], v[154:155]
    v_pk_add_f32 v[48:49], v[48:49], v[156:157]
    v_perm_b32 v18, v155, v154, s52
    v_perm_b32 v19, v157, v156, s52
    v_lshl_or_b32 v18, v19, 16, v18
    v_bitop3_b32 v17, v18, v4, v17 bitop3:0xbe
    s_waitcnt vmcnt(2)
    v_pk_add_f32 v[46:47], v[46:47], v[158:159]
    v_pk_add_f32 v[48:49], v[48:49], v[160:161]
    v_perm_b32 v18, v159, v158, s52
    v_perm_b32 v19, v161, v160, s52
    v_lshl_or_b32 v18, v19, 16, v18
    v_bitop3_b32 v17, v18, v4, v17 bitop3:0xbe
    s_waitcnt vmcnt(1)
    v_pk_add_f32 v[46:47], v[46:47], v[162:163]
    v_pk_add_f32 v[48:49], v[48:49], v[164:165]
    v_perm_b32 v18, v163, v162, s52
    v_perm_b32 v19, v165, v164, s52
    v_lshl_or_b32 v18, v19, 16, v18
    v_bitop3_b32 v17, v18, v4, v17 bitop3:0xbe
    s_waitcnt vmcnt(0)
    v_pk_add_f32 v[46:47], v[46:47], v[166:167]
    v_pk_add_f32 v[48:49], v[48:49], v[168:169]
    v_cvt_pk_bf16_f32 v46, v46, v47
    v_cvt_pk_bf16_f32 v47, v48, v49
    ds_write_b64 v12, v[46:47] offset:2560
    v_perm_b32 v18, v167, v166, s52
    v_perm_b32 v19, v169, v168, s52
    v_lshl_or_b32 v18, v19, 16, v18
    v_bitop3_b32 v17, v18, v4, v17 bitop3:0xbe
    v_cmp_ne_u32 vcc, 0, v17
    s_cbranch_vccz L_qspin_ok
    s_add_u32 s68, s68, 1
    s_max_u32 s66, s68, 5
    s_bitcmp1_b32 s66, 0
    s_cselect_b32 s66, 1310720, 0
    s_add_u32 s66, s30, s66
    s_addc_u32 s67, s31, 0
    s_add_u32 s53, s53, 1
    s_cmp_lt_u32 s53, 0x40000
    s_cbranch_scc1 L_qspin
L_qspin_ok:
    s_waitcnt lgkmcnt(0)
    s_barrier
    s_mov_b32 s45, 0x3fb8aa3b
    s_mov_b32 s46, 0x05040100
    s_mov_b32 s47, 0x07060302
    s_add_u32 s66, s30, 1310720
    s_addc_u32 s67, s31, 0
    s_mov_b32 s68, 0
    s_mul_i32 s55, s32, 1152
    s_lshl2_add_u32 s56, s33, s55
    s_add_u32 s56, s56, 950272
    v_lshl_add_u32 v22, v3, 7, s56
    s_barrier
    ds_read_b128 v[138:141], v13 offset:3072
    ds_read_b128 v[142:145], v13 offset:3104
    s_waitcnt lgkmcnt(1)
    v_max3_f32 v46, v138, v139, v140
    v_max_f32 v46, v46, v141
    v_sub_f32 v138, v138, v46
    v_sub_f32 v139, v139, v46
    v_sub_f32 v140, v140, v46
    v_sub_f32 v141, v141, v46
    v_mul_f32 v138, s45, v138
    v_mul_f32 v139, s45, v139
    v_mul_f32 v140, s45, v140
    v_mul_f32 v141, s45, v141
    v_exp_f32 v138, v138
    v_exp_f32 v139, v139
    v_exp_f32 v140, v140
    v_exp_f32 v141, v141
    s_waitcnt lgkmcnt(0)
    v_mul_f32 v47, v138, v142
    v_fmac_f32 v47, v139, v143
    v_fmac_f32 v47, v140, v144
    v_fmac_f32 v47, v141, v145
    v_rcp_f32 v14, v47
    v_mov_b32 v48, 0
    v_mov_b32 v49, v4
    v_and_b32 v15, 3, v0
    v_lshl_add_u32 v15, v15, 5, v13
    v_add_u32 v15, s44, v15
    s_mov_b32 exec_lo, 15
    s_mov_b32 exec_hi, 15
    global_store_dwordx4 v15, v[46:49], s[66:67] offset:1024
    s_mov_b64 exec, -1
    v_mul_f32 v50, v138, v14
    v_mul_f32 v51, v139, v14
    v_mul_f32 v52, v140, v14
    v_mul_f32 v53, v141, v14
    s_barrier
    ds_read_b128 v[138:141], v6 offset:4096
    ds_read_b128 v[142:145], v6 offset:5120
    ds_read_b128 v[146:149], v6 offset:6144
    ds_read_b128 v[150:153], v6 offset:7168
    s_waitcnt lgkmcnt(3)
    v_pk_mul_f32 v[30:31], v[138:139], v[50:51] op_sel:[0,0] op_sel_hi:[1,0]
    v_pk_mul_f32 v[32:33], v[140:141], v[50:51] op_sel:[0,0] op_sel_hi:[1,0]
    s_waitcnt lgkmcnt(2)
    v_pk_fma_f32 v[30:31], v[142:143], v[50:51], v[30:31] op_sel:[0,1,0] op_sel_hi:[1,1,1]
    v_pk_fma_f32 v[32:33], v[144:145], v[50:51], v[32:33] op_sel:[0,1,0] op_sel_hi:[1,1,1]
    s_waitcnt lgkmcnt(1)
    v_pk_fma_f32 v[30:31], v[146:147], v[52:53], v[30:31] op_sel:[0,0,0] op_sel_hi:[1,0,1]
    v_pk_fma_f32 v[32:33], v[148:149], v[52:53], v[32:33] op_sel:[0,0,0] op_sel_hi:[1,0,1]
    s_waitcnt lgkmcnt(0)
    v_pk_fma_f32 v[30:31], v[150:151], v[52:53], v[30:31] op_sel:[0,1,0] op_sel_hi:[1,1,1]
    v_pk_fma_f32 v[32:33], v[152:153], v[52:53], v[32:33] op_sel:[0,1,0] op_sel_hi:[1,1,1]
    v_cvt_pk_bf16_f32 v31, v30, v31
    v_cvt_pk_bf16_f32 v32, 0, v32
    v_cvt_pk_bf16_f32 v33, 0, v33
    v_perm_b32 v30, v31, v4, s46
    v_perm_b32 v31, v31, v4, s47
    global_store_dwordx4 v24, v[30:33], s[66:67]
    s_barrier
    v_mov_b32 v8, 0
    s_cmp_eq_u32 s40, 2
    s_barrier
    s_cbranch_scc1 L_bst
    ds_read_b32 v8, v8 offset:18176
    s_waitcnt lgkmcnt(0)
    v_cmp_ne_u32 vcc, 0, v8
    s_cbranch_vccz L_nobst
L_bst:
    s_bfm_b64 exec, 32, 0
    global_store_dwordx4 v28, v[38:41], s[30:31] sc1
    s_mov_b64 exec, -1
    global_store_dwordx4 v24, v[30:33], s[30:31] sc1
    s_mov_b32 exec_lo, 15
    s_mov_b32 exec_hi, 15
    global_store_dwordx4 v15, v[46:49], s[30:31] offset:1024 sc1
    s_mov_b64 exec, -1
L_nobst:
    s_cmp_eq_u32 s40, 2
    s_cbranch_scc1 L_fin
    s_cmp_eq_u32 s40, 1
    s_cbranch_scc1 L_hW
    s_barrier
    s_branch L_fin
L_hW:
    s_add_u32 s44, s32, 1
    s_mul_i32 s44, s44, 663552
    s_lshl_b32 s45, s41, 13
    s_add_u32 s44, s44, s45
    s_sub_u32 s44, s44, 516096
    v_lshl_add_u32 v8, v1, 7, s44
    s_lshl3_add_u32 s44, s41, s32
    s_lshl_b32 s44, s44, 8
    s_add_u32 s44, s44, 524288
    v_add_u32 v22, s44, v6
    s_bfm_b64 exec, 16, 0
    s_barrier
    ds_read_b128 v[138:141], v6 offset:0
    ds_read_b128 v[142:145], v6 offset:512
    ds_read_b128 v[146:149], v6 offset:1024
    ds_read_b128 v[150:153], v6 offset:1536
    s_waitcnt lgkmcnt(2)
    v_pk_add_f32 v[34:35], v[138:139], v[142:143]
    v_pk_add_f32 v[36:37], v[140:141], v[144:145]
    s_waitcnt lgkmcnt(1)
    v_pk_add_f32 v[34:35], v[34:35], v[146:147]
    v_pk_add_f32 v[36:37], v[36:37], v[148:149]
    s_waitcnt lgkmcnt(0)
    v_pk_add_f32 v[34:35], v[34:35], v[150:151]
    v_pk_add_f32 v[36:37], v[36:37], v[152:153]
    v_perm_b32 v34, v34, v4, s48
    v_perm_b32 v35, v35, v4, s49
    v_perm_b32 v36, v36, v4, s50
    v_perm_b32 v37, v37, v4, s51
    global_store_dwordx4 v22, v[34:37], s[30:31] sc1
    s_mov_b64 exec, -1
    global_load_dword v7, v8, s[24:25]
    v_add_u32 v8, 73728, v8
    global_load_dword v7, v8, s[24:25]
    v_add_u32 v8, 73728, v8
    global_load_dword v7, v8, s[24:25]
    v_add_u32 v8, 73728, v8
    global_load_dword v7, v8, s[24:25]
    v_add_u32 v8, 73728, v8
    global_load_dword v7, v8, s[24:25]
    v_add_u32 v8, 73728, v8
    global_load_dword v7, v8, s[24:25]
    v_add_u32 v8, 73728, v8
    global_load_dword v7, v8, s[24:25]
    s_mul_i32 s44, s32, 18
    s_lshr_b32 s44, s44, 3
    s_mul_i32 s44, s44, 18432
    s_mul_i32 s45, s41, 6144
    s_add_u32 s44, s44, s45
    s_add_u32 s44, s44, 589824
    v_lshl_add_u32 v8, v1, 7, s44
    s_bfm_b64 exec, 48, 0
    global_load_dword v7, v8, s[30:31]
    s_mov_b64 exec, -1
    s_bfm_b64 exec, 32, 0
    global_store_dwordx4 v28, v[38:41], s[30:31] sc1
    s_mov_b64 exec, -1
    global_store_dwordx4 v24, v[30:33], s[30:31] sc1
    s_mov_b32 exec_lo, 15
    s_mov_b32 exec_hi, 15
    global_store_dwordx4 v15, v[46:49], s[30:31] offset:1024 sc1
    s_mov_b64 exec, -1
L_fin:
L_end:
    s_endpgm
L_code_end:
.if (L_code_end - sequential_preLN__sliding_block_cached__glu_gated_geglu__decode_kernel) < 12800
.fill (12800 - (L_code_end - sequential_preLN__sliding_block_cached__glu_gated_geglu__decode_kernel))/4, 4, 0xbf800000
.endif
.section .rodata,"a"
.p2align 6
.amdhsa_kernel sequential_preLN__sliding_block_cached__glu_gated_geglu__decode_kernel
  .amdhsa_next_free_vgpr 242
  .amdhsa_next_free_sgpr 69
  .amdhsa_accum_offset 244
  .amdhsa_group_segment_fixed_size 0
  .amdhsa_kernarg_size 96
  .amdhsa_user_sgpr_count 2
  .amdhsa_user_sgpr_kernarg_segment_ptr 1
  .amdhsa_system_sgpr_workgroup_id_x 1
  .amdhsa_float_denorm_mode_32 3
.end_amdhsa_kernel
```
